```python
import torch

def _softmax(x, axis=-1):
    return torch.softmax(x, dim=axis)
def _gelu(x):
    return torch.nn.functional.gelu(x, approximate="tanh")
def _silu(x):
    return torch.nn.functional.silu(x)
def _sigmoid(x):
    return torch.sigmoid(x)
def _layernorm(x, axis=-1, eps=1e-5):
    m = x.mean(dim=axis, keepdim=True)
    v = x.var(dim=axis, keepdim=True, unbiased=False)
    return (x - m) / torch.sqrt(v + eps)
def _scatter_add(tgt, idx, src, axis=0):
    return tgt.clone().index_add_(axis, idx, src)
def _segment_sum(src, seg, n):
    out = torch.zeros((n,) + src.shape[1:], dtype=src.dtype)
    return out.index_add_(0, seg, src)
def _pad(x, pw):
    flat = tuple(v for pair in reversed(pw) for v in pair)
    return torch.nn.functional.pad(x, flat)

kernel_name = 'interleave_layers__spectral_gfnet__spectral_gfnet__prompt'

def setup_inputs():

    _w = (lambda a: (lambda t: t.to(torch.bfloat16) if t.is_floating_point() else t)(torch.as_tensor(a)))
    def _A_setup():
        B, S, D = 1, 2048, 640
        Df = D // 2 + 1
        return {
            "x": _w((lambda *s: torch.randn(*s, dtype=torch.bfloat16) * 0.05)(B, S, D)),
            "w_r": _w((lambda *s: torch.randn(*s, dtype=torch.bfloat16) * 0.2)(S, Df) * 0.02),
            "w_i": _w((lambda *s: torch.randn(*s, dtype=torch.bfloat16) * 0.2)(S, Df) * 0.02),
        }
    _A_in = _A_setup()

    def _B_setup():
        B, S, D = 1, 2048, 640
        Df = D // 2 + 1
        return {
            "x": _w((lambda *s: torch.randn(*s, dtype=torch.bfloat16) * 0.05)(B, S, D)),
            "w_r": _w((lambda *s: torch.randn(*s, dtype=torch.bfloat16) * 0.2)(S, Df) * 0.02),
            "w_i": _w((lambda *s: torch.randn(*s, dtype=torch.bfloat16) * 0.2)(S, Df) * 0.02),
        }
    _B_in = _B_setup()

    return {
        "A_x": _A_in["x"],
        "A_w_r": _A_in["w_r"],
        "A_w_i": _A_in["w_i"],
        "B_x": _B_in["x"],
        "B_w_r": _B_in["w_r"],
        "B_w_i": _B_in["w_i"],
    }

def reference(A_x, A_w_r, A_w_i, B_x, B_w_r, B_w_i):
    def _A_ref(x, w_r, w_i):
        B, S, D = x.shape
        X = (lambda x, axes=(-2,-1): torch.fft.rfft2(x.float(), dim=axes))(x, axes=(-2, -1))
        W = w_r + 1j * w_i
        X = X * W
        y = (lambda x, s, axes=(-2,-1): torch.fft.irfft2(x, s=s, dim=axes).to(torch.bfloat16))(X, (S, D), axes=(-2, -1))
        return y

    def _B_ref(x, w_r, w_i):
        B, S, D = x.shape
        X = (lambda x, axes=(-2,-1): torch.fft.rfft2(x.float(), dim=axes))(x, axes=(-2, -1))
        W = w_r + 1j * w_i
        X = X * W
        y = (lambda x, s, axes=(-2,-1): torch.fft.irfft2(x, s=s, dim=axes).to(torch.bfloat16))(X, (S, D), axes=(-2, -1))
        return y

    x = A_x
    x = x + _A_ref(_layernorm(x, axis=-1), A_w_r, A_w_i)
    x = x + _B_ref(_layernorm(x, axis=-1), B_w_r, B_w_i)
    x = x + _A_ref(_layernorm(x, axis=-1), A_w_r, A_w_i)
    x = x + _B_ref(_layernorm(x, axis=-1), B_w_r, B_w_i)
    return x
```

```asm
; @launch grid=(256,1,1) block=(1024,1,1) lds=94912
.amdgcn_target "amdgcn-amd-amdhsa--gfx950"
.text
.p2align 12
.fill 832, 4, 0xbf810000
.globl interleave_layers__spectral_gfnet__spectral_gfnet__prompt_kernel
.p2align 8
.type interleave_layers__spectral_gfnet__spectral_gfnet__prompt_kernel,@function
interleave_layers__spectral_gfnet__spectral_gfnet__prompt_kernel:
    s_cmp_ge_u32 s2, 256
    s_cbranch_scc1 L_end
    s_load_dwordx16 s[36:51], s[0:1], 0
    s_load_dwordx2 s[52:53], s[0:1], 64
    v_add_u32 v0, 0x300, v0
    v_and_b32 v0, 0x3ff, v0
    v_lshrrev_b32 v78, 6, v0
    v_and_b32 v1, 63, v0
    v_readfirstlane_b32 s24, v78
    v_lshlrev_b32 v99, 4, v1
    v_and_b32 v2, 15, v1
    v_lshrrev_b32 v3, 4, v1
    v_lshrrev_b32 v92, 5, v1
    s_and_b32 s32, s2, 7
    s_lshr_b32 s34, s2, 3
    s_lshl_b32 s25, s32, 5
    s_add_u32 s25, s25, s34
    s_and_b32 s33, s24, 3
    s_cmp_lt_u32 s24, 12
    s_cbranch_scc1 L_common
    s_setprio 3
    s_getpc_b64 s[30:31]
    v_and_b32 v76, 0xff, v0
    v_mul_u32_u24 v76, 28, v76
    v_mov_b32 v77, 0
    v_lshl_add_u64 v[76:77], v[76:77], 0, s[30:31]
    global_load_dword v84, v[76:77], off offset:2048
    s_and_b32 s30, s25, 12
    s_lshl_b32 s30, s30, 7
    s_and_b32 s31, s25, 0xf0
    s_add_u32 s30, s30, s31
    s_and_b32 s31, s25, 3
    s_lshl2_add_u32 s30, s31, s30
    s_mul_i32 s35, s30, 1280
    s_and_b32 s30, s24, 1
    s_mul_i32 s31, s33, 1536
    s_mul_i32 s26, s30, 3584
    s_add_u32 m0, s31, s26
    s_mul_i32 s30, s30, 326144
    s_add_u32 s30, s30, s31
    s_add_u32 s26, s30, s35
    s_mov_b32 s6, 2621440
    s_mov_b32 s7, 0x00020000
    v_mul_u32_u24 v92, 81664, v92
    v_add_u32 v92, v92, v99
    s_bitcmp1_b32 s2, 0
    s_cselect_b32 s65, 322, 2
    s_lshr_b32 s57, s2, 1
    s_lshr_b32 s30, s57, 4
    s_and_b32 s31, s57, 3
    s_lshl2_add_u32 s31, s31, s33
    s_lshl3_add_u32 s30, s31, s30
    s_and_b32 s31, s57, 12
    s_lshl_b32 s31, s31, 7
    s_add_u32 s30, s30, s31
    s_mul_i32 s30, s30, 642
    s_add_u32 s30, s30, s65
    s_and_b32 s30, s30, 0xfffffff0
    s_add_u32 s31, s30, 164352
    s_mul_i32 s58, s33, 864
    s_add_u32 s58, s58, 39616
    s_mov_b32 s18, 1314816
    s_mov_b32 s19, 0x00020000
    s_mov_b32 s22, 1314816
    s_mov_b32 s23, 0x00020000
    s_cmp_ge_u32 s24, 14
    s_waitcnt lgkmcnt(0)
    s_mov_b64 s[4:5], s[36:37]
    buffer_load_dwordx4 v99, s[4:7], s26 offen nt lds
    buffer_load_dwordx4 v99, s[4:7], s26 offen offset:1024 nt lds
    s_cbranch_scc1 L_nox
    buffer_load_dwordx4 v99, s[4:7], s26 offen offset:2048 nt lds
L_nox:
    s_mov_b64 s[16:17], s[38:39]
    s_mov_b64 s[20:21], s[40:41]
    s_mov_b32 exec_lo, 0x1fffff
    s_mov_b32 exec_hi, exec_lo
    s_add_u32 m0, s58, 0
    s_nop 0
    buffer_load_dwordx4 v92, s[16:19], s30 offen nt lds
    s_add_u32 m0, s58, 3456
    s_nop 0
    buffer_load_dwordx4 v92, s[16:19], s31 offen nt lds
    s_add_u32 m0, s58, 6912
    s_nop 0
    buffer_load_dwordx4 v92, s[20:23], s30 offen nt lds
    s_add_u32 m0, s58, 10368
    s_nop 0
    buffer_load_dwordx4 v92, s[20:23], s31 offen nt lds
    s_mov_b64 exec, -1
    s_cmp_lg_u32 s24, 12
    s_cbranch_scc1 L_nowarm
    s_sub_u32 s30, s2, 160
    s_cmp_ge_u32 s30, 64
    s_cbranch_scc1 L_nowarm
    s_xor_b32 s30, s30, 1
    s_and_b32 s31, s30, 32
    s_lshl_b32 s31, s31, 16
    s_and_b32 s30, s30, 31
    s_lshl_b32 s30, s30, 8
    s_add_u32 s30, s30, s31
    s_add_u32 s30, s30, 0x1e0000
    s_add_u32 s31, s30, 0x2000
    s_load_dword s42, s[52:53], s30
    s_load_dword s43, s[52:53], s31
L_nowarm:
    s_setprio 0
L_common:
    v_cvt_f32_u32 v4, v2
    v_cvt_f32_u32 v5, v3
    s_bfm_b64 s[60:61], 32, 32
    s_mov_b32 s62, 0xaaaaaaaa
    s_mov_b32 s63, s62
    s_cmp_ge_u32 s24, 12
    s_cbranch_scc1 L_c1done
    s_mul_i32 s30, s33, 1280
    v_and_b32 v96, 31, v1
    v_lshl_add_u32 v96, v96, 3, s30
    v_lshl_add_u32 v95, v1, 3, s30
    v_mov_b32 v73, 0x3e800000
    s_and_b32 s30, s24, 12
    v_lshl_add_u32 v72, s30, 2, v2
    s_cselect_b32 s30, 0, 0x00020002
    s_mov_b32 s31, s30
    v_lshrrev_b32 v68, 1, v72
    v_mul_u32_u24 v93, 464, v68
    v_lshl_add_u32 v93, v72, 5, v93
    v_lshl_add_u32 v93, v3, 3, v93
    v_lshl_add_u32 v93, s33, 7, v93
    v_cndmask_b32 v68, v68, 20, s[30:31]
    s_andn2_b64 s[30:31], s[62:63], s[30:31]
    v_cvt_f32_u32 v68, v68
    v_cndmask_b32 v69, 0, v73, s[30:31]
    v_mul_f32 v70, 0x3dcccccd, v68
    v_mul_f32 v68, 0x3ccccccd, v68
    v_fmac_f32 v69, v70, v5
    v_add_f32 v77, v68, v69
    v_fmamk_f32 v78, v68, 0x40000000, v69
    v_fmamk_f32 v79, v68, 0x40400000, v69
    v_fmamk_f32 v80, v68, 0x41800000, v69
    v_fmamk_f32 v81, v68, 0x41880000, v69
    v_fmamk_f32 v82, v68, 0x41900000, v69
    v_fmamk_f32 v83, v68, 0x41980000, v69
    v_cos_f32 v76, v69
    v_cos_f32 v77, v77
    v_cos_f32 v78, v78
    v_cos_f32 v79, v79
    v_cos_f32 v80, v80
    v_cos_f32 v81, v81
    v_cos_f32 v82, v82
    v_cos_f32 v83, v83
    v_cvt_pk_bf16_f32 v8, v76, v77
    v_cvt_pk_bf16_f32 v9, v78, v79
    v_cvt_pk_bf16_f32 v10, v80, v81
    v_cvt_pk_bf16_f32 v11, v82, v83
    v_fmamk_f32 v76, v68, 0x42000000, v69
    v_fmamk_f32 v77, v68, 0x42040000, v69
    v_fmamk_f32 v78, v68, 0x42080000, v69
    v_fmamk_f32 v79, v68, 0x420c0000, v69
    v_cos_f32 v76, v76
    v_cos_f32 v77, v77
    v_cos_f32 v78, v78
    v_cos_f32 v79, v79
    v_cvt_pk_bf16_f32 v12, v76, v77
    v_cvt_pk_bf16_f32 v13, v78, v79
    v_cndmask_b32 v14, v12, 0, s[60:61]
    v_cndmask_b32 v15, v13, 0, s[60:61]
    v_mov_b32 v12, 0
    v_mov_b32 v13, 0
    s_waitcnt lgkmcnt(0)
L_c1done:
    s_load_dword s27, s[52:53], 0x0
    s_cmp_lt_u32 s2, 160
    s_cselect_b32 s3, 1, 0
    s_mov_b64 s[8:9], s[52:53]
    s_mov_b32 s10, 0xe00000
    s_mov_b32 s11, 0x00020000
    s_mov_b64 s[28:29], 0
    v_mov_b32 v7, 0x00010001
    s_mov_b32 s66, 0x80008000
    s_movk_i32 s67, 0x3fff
    v_and_b32 v98, 112, v99
    v_mov_b32 v23, 0
    s_cmp_ge_u32 s24, 10
    s_cbranch_scc1 L_wk0
    s_and_b64 s[30:31], s[60:61], s[62:63]
    v_mov_b32 v126, s66
    v_cndmask_b32 v126, 0, v126, s[30:31]
    v_and_b32 v74, 16, v1
    v_xor_b32 v94, v92, v2
    v_lshl_add_u32 v94, v94, 5, v74
    s_mul_i32 s30, s24, 1056
    v_add_u32 v94, s30, v94
    v_cvt_f32_u32 v74, v74
    v_mul_f32 v74, 0.5, v74
    v_cndmask_b32 v75, 0, -v73, s[60:61]
    v_cvt_f32_u32 v72, s24
    v_fmamk_f32 v72, v4, 0x41a00000, v72
    v_add_f32 v68, 0.5, v72
    v_mul_f32 v68, 0x3b4ccccd, v68
    v_fma_f32 v69, v68, v74, v75
    v_add_f32 v77, v68, v69
    v_fmamk_f32 v78, v68, 0x40000000, v69
    v_fmamk_f32 v79, v68, 0x40400000, v69
    v_fmamk_f32 v80, v68, 0x40800000, v69
    v_fmamk_f32 v81, v68, 0x40a00000, v69
    v_fmamk_f32 v82, v68, 0x40c00000, v69
    v_fmamk_f32 v83, v68, 0x40e00000, v69
    v_cos_f32 v76, v69
    v_cos_f32 v77, v77
    v_cos_f32 v78, v78
    v_cos_f32 v79, v79
    v_cos_f32 v80, v80
    v_cos_f32 v81, v81
    v_cos_f32 v82, v82
    v_cos_f32 v83, v83
    v_cvt_pk_bf16_f32 v24, v76, v77
    v_cvt_pk_bf16_f32 v25, v78, v79
    v_cvt_pk_bf16_f32 v26, v80, v81
    v_cvt_pk_bf16_f32 v27, v82, v83
    v_mul_f32 v68, 0x3b4ccccd, v72
    s_cmp_lg_u32 s24, 0
    s_cbranch_scc1 L_c2n
    s_mov_b32 s30, 0xff00ff00
    s_mov_b32 s31, s30
    v_cndmask_b32 v68, 1.0, 0.5, s[30:31]
    v_add_f32 v68, v68, v4
    v_mul_f32 v68, 0x3d800000, v68
    s_not_b32 s31, s31
    v_cndmask_b32 v75, v73, -v73, s[60:61]
    v_cndmask_b32 v75, 0, v75, s[30:31]
L_c2n:
    v_fma_f32 v69, v68, v74, v75
    v_add_f32 v77, v68, v69
    v_fmamk_f32 v78, v68, 0x40000000, v69
    v_fmamk_f32 v79, v68, 0x40400000, v69
    v_fmamk_f32 v80, v68, 0x40800000, v69
    v_fmamk_f32 v81, v68, 0x40a00000, v69
    v_fmamk_f32 v82, v68, 0x40c00000, v69
    v_fmamk_f32 v83, v68, 0x40e00000, v69
    v_cos_f32 v76, v69
    v_cos_f32 v77, v77
    v_cos_f32 v78, v78
    v_cos_f32 v79, v79
    v_cos_f32 v80, v80
    v_cos_f32 v81, v81
    v_cos_f32 v82, v82
    v_cos_f32 v83, v83
    v_cvt_pk_bf16_f32 v16, v76, v77
    v_cvt_pk_bf16_f32 v17, v78, v79
    v_cvt_pk_bf16_f32 v18, v80, v81
    v_cvt_pk_bf16_f32 v19, v82, v83
    s_cmp_lg_u32 s24, 0
    s_cbranch_scc1 L_c2done
    v_mov_b32 v20, 0
    v_mov_b32 v21, 0
    v_mov_b32 v22, 0
    v_mov_b32 v23, 0
    s_mov_b64 exec, s[30:31]
    v_swap_b32 v16, v20
    v_swap_b32 v17, v21
    v_swap_b32 v18, v22
    v_swap_b32 v19, v23
    s_mov_b32 exec_lo, 0x00800080
    s_mov_b32 exec_hi, exec_lo
    v_mov_b32 v20, 0
    v_mov_b32 v21, 0
    v_mov_b32 v22, 0
    v_mov_b32 v23, 0
    s_mov_b32 exec_hi, 0
    v_mov_b32 v16, 0xbf353f35
    v_mov_b32 v17, 0xbf353f35
    v_mov_b32 v18, 0xbf353f35
    v_mov_b32 v19, 0xbf353f35
    s_mov_b64 exec, -1
    s_branch L_c2done
L_wk0:
    v_mov_b32 v125, 0
    ds_write_b32 v125, v125 offset:22912
    s_sub_u32 s50, s24, 10
L_wk1:
    s_bitcmp1_b32 s2, 0
    s_cselect_b32 s30, 1, 3
    s_cselect_b32 s31, 1, 0
    s_cselect_b32 s26, 322, 2
    v_bfe_u32 v68, v1, 3, 1
    v_mul_u32_u24 v68, s30, v68
    v_add_u32 v68, s31, v68
    v_lshl_add_u32 v69, v3, 2, v68
    v_lshl_add_u32 v98, v69, 7, v98
    v_lshl_add_u32 v68, v68, 2, v3
    v_bfe_u32 v69, v1, 2, 1
    v_lshl_add_u32 v69, s50, 1, v69
    v_mad_u32_u24 v97, v68, 40, v69
    v_add_u32 v90, 10, v97
    s_cmp_lg_u32 s50, 0
    s_cbranch_scc1 L_wk
    s_mov_b32 exec_lo, 0x000f000f
    s_mov_b32 exec_hi, exec_lo
    v_add_u32 v97, 40, v97
    s_lshl_b64 exec, exec, 8
    v_add_u32 v97, 20, v97
    s_mov_b64 exec, -1
L_wk:
    v_and_b32 v70, 3, v1
    v_mul_u32_u24 v70, 864, v70
    v_subrev_u32 v70, s26, v70
    v_sub_u32 v69, 640, v97
    v_min_u32 v97, v97, v69
    v_lshl_add_u32 v97, v97, 1, v70
    v_sub_u32 v69, 640, v90
    v_min_u32 v90, v90, v69
    v_lshl_add_u32 v90, v90, 1, v70
    s_lshr_b32 s57, s2, 1
    s_mov_b32 s59, 39616
    s_cmp_eq_u32 s28, 1
    s_cbranch_scc1 L_wb3
L_c2done:
    s_cmp_eq_u32 s3, 0
    s_cbranch_scc1 L_n0
    s_and_b32 s30, s24, 7
    v_cvt_f32_u32 v70, s30
    v_fmamk_f32 v69, v4, 0x41000000, v70
    v_mul_f32 v69, 0x3b000000, v69
    v_mul_f32 v68, 0x3e800000, v69
    v_mul_f32 v69, v69, v5
    v_add_f32 v41, v68, v69
    v_fmamk_f32 v42, v68, 0x40000000, v69
    v_fmamk_f32 v43, v68, 0x40400000, v69
    v_sin_f32 v44, v69
    v_sin_f32 v45, v41
    v_sin_f32 v46, v42
    v_sin_f32 v47, v43
    v_cos_f32 v40, v69
    v_cos_f32 v41, v41
    v_cos_f32 v42, v42
    v_cos_f32 v43, v43
L_n0:
    s_cmp_ge_u32 s24, 12
    s_cbranch_scc1 L_var
    s_setprio 1
    s_waitcnt lgkmcnt(0)
    s_barrier
    ds_read_b64_tr_b16 v[28:29], v95 offset:0
    ds_read_b64_tr_b16 v[30:31], v95 offset:512
    ds_read_b64_tr_b16 v[32:33], v96 offset:1024
    ds_read_b64_tr_b16 v[34:35], v95 offset:5120
    ds_read_b64_tr_b16 v[36:37], v95 offset:5632
    ds_read_b64_tr_b16 v[38:39], v96 offset:6144
    v_not_b32 v6, s27
    s_waitcnt lgkmcnt(3)
    v_mfma_f32_16x16x32_bf16 v[68:71], v[28:31], v[8:11], 0
    v_mfma_f32_16x16x32_bf16 v[68:71], v[30:33], v[12:15], v[68:71]
    s_waitcnt lgkmcnt(0)
    v_mfma_f32_16x16x32_bf16 v[72:75], v[34:37], v[8:11], 0
    v_mfma_f32_16x16x32_bf16 v[72:75], v[36:39], v[12:15], v[72:75]
    s_mul_i32 s30, s25, 10368
    s_lshl_b32 s31, s24, 10
    s_add_u32 s30, s30, s31
    s_add_u32 s30, s30, 0x400000
    s_cmp_ge_u32 s24, 10
    v_cvt_pk_bf16_f32 v84, v68, v69
    v_cvt_pk_bf16_f32 v85, v70, v71
    ds_write_b64 v93, v[84:85] offset:10240
    v_cvt_pk_bf16_f32 v86, v72, v73
    v_cvt_pk_bf16_f32 v87, v74, v75
    ds_write_b64 v93, v[86:87] offset:10304
L_s1done:
    s_waitcnt lgkmcnt(0)
    s_barrier
    s_cbranch_scc1 L_s2other
    ds_read_b128 v[28:31], v94 offset:10240
    ds_read_b128 v[32:35], v94 offset:10768
    v_bitop3_b32 v89, v6, v7, v126 bitop3:0x6a
    v_lshlrev_b32 v92, 2, v1
    s_cmp_eq_u32 s24, 0
    s_waitcnt lgkmcnt(1)
    v_xor_b32 v28, v126, v28
    v_xor_b32 v29, v126, v29
    v_xor_b32 v30, v126, v30
    v_xor_b32 v31, v126, v31
    s_waitcnt lgkmcnt(0)
    v_xor_b32 v32, v126, v32
    v_xor_b32 v33, v126, v33
    v_xor_b32 v34, v126, v34
    v_xor_b32 v35, v126, v35
    v_mfma_f32_16x16x32_bf16 v[68:71], v[16:19], v[28:31], 0
    s_cbranch_scc1 L_s2sp
    v_mfma_f32_16x16x32_bf16 v[72:75], v[24:27], v[32:35], 0
    s_nop 7
L_s2n:
    s_nop 2
    v_cvt_pk_bf16_f32 v84, v68, v72
    v_bitop3_b32 v84, v84, v7, v89 bitop3:0x9a
    buffer_store_dword v84, v92, s[8:11], s30 offen sc1
    v_cvt_pk_bf16_f32 v85, v69, v73
    v_bitop3_b32 v85, v85, v7, v89 bitop3:0x9a
    buffer_store_dword v85, v92, s[8:11], s30 offen offset:256 sc1
    v_cvt_pk_bf16_f32 v86, v70, v74
    v_bitop3_b32 v86, v86, v7, v89 bitop3:0x9a
    buffer_store_dword v86, v92, s[8:11], s30 offen offset:512 sc1
    v_cvt_pk_bf16_f32 v87, v71, v75
    v_bitop3_b32 v87, v87, v7, v89 bitop3:0x9a
    buffer_store_dword v87, v92, s[8:11], s30 offen offset:768 sc1
    s_branch L_s2done
L_s2sp:
    v_mfma_f32_16x16x32_bf16 v[76:79], v[20:23], v[28:31], 0
    v_mfma_f32_16x16x32_bf16 v[72:75], v[24:27], v[32:35], 0
    s_nop 6
    v_cndmask_b32 v68, v68, v76, s[62:63]
    v_cndmask_b32 v69, v69, v77, s[62:63]
    v_cndmask_b32 v70, v70, v78, s[62:63]
    v_cndmask_b32 v71, v71, v79, s[62:63]
    s_branch L_s2n
L_var:
    s_cmp_ge_u32 s24, 14
    s_cbranch_scc1 L_var2
    s_waitcnt lgkmcnt(0)
    v_not_b32 v6, s27
    s_waitcnt vmcnt(4)
    s_barrier
    s_cmp_lg_u32 s24, 12
    s_cbranch_scc1 L_novote
    s_sub_u32 s30, s2, 160
    s_cmp_ge_u32 s30, 64
    s_cbranch_scc1 L_novote
    s_and_b32 s31, s30, 32
    s_lshl_b32 s31, s31, 16
    s_and_b32 s30, s30, 31
    s_lshl_b32 s30, s30, 8
    s_add_u32 s30, s30, s31
    s_add_u32 s30, s30, 0x1e0000
    s_add_u32 s31, s30, 0x2000
    s_load_dword s42, s[52:53], s30
    s_load_dword s43, s[52:53], s31
    s_waitcnt lgkmcnt(1)
    s_bfe_u32 s31, s2, 0x10002
    s_xor_b32 s31, s31, 1
    s_getreg_b32 s30, hwreg(HW_REG_IB_STS, 8, 1)
    s_xor_b32 s30, s30, s31
    v_and_or_b32 v88, v6, -2, s30
    s_lshl2_add_u32 s30, s2, 0x1d80
    s_mov_b64 exec, 1
    buffer_store_dword v88, v1, s[8:11], s30 offen sc1
    s_mov_b64 exec, -1
    s_barrier
    v_mov_b32 v71, 1
    s_mov_b64 exec, 1
    s_waitcnt vmcnt(1)
    ds_add_u32 v125, v71 offset:22912
    s_mov_b64 exec, -1
    s_branch L_wsp
L_novote:
    s_cmp_ge_u32 s24, 10
    s_branch L_s1done
L_var2:
    v_and_b32 v68, 1, v3
    v_mul_u32_u24 v68, 4480, v68
    s_movk_i32 s30, 640
    v_mad_u32_u24 v68, v3, s30, v68
    v_lshl_add_u32 v68, v2, 4, v68
    s_and_b32 s31, s24, 1
    s_mul_i32 s30, s31, 2560
    v_add_u32 v68, s30, v68
    v_mov_b32 v76, 0
    v_mov_b32 v77, 0
    v_mov_b32 v78, 0x3f803f80
    v_and_b32 v89, 3, v1
    v_and_b32 v88, 12, v1
    v_lshlrev_b32 v88, 12, v88
    v_lshl_add_u32 v88, v3, 13, v88
    v_lshl_add_u32 v88, v89, 2, v88
    v_lshlrev_b32 v89, 6, v89
    s_and_b32 s30, s25, 0xfc
    s_add_u32 s30, s30, s25
    s_lshl2_add_u32 s30, s31, s30
    s_lshl4_add_u32 s26, s30, 0x10000
    s_setprio 2
    s_waitcnt lgkmcnt(0)
    v_not_b32 v6, s27
    s_waitcnt vmcnt(4)
    s_barrier
    ds_read_b128 v[8:11], v68 offset:0
    ds_read_b128 v[12:15], v68 offset:256
    ds_read_b128 v[16:19], v68 offset:512
    ds_read_b128 v[20:23], v68 offset:768
    ds_read_b128 v[24:27], v68 offset:1024
    s_waitcnt lgkmcnt(4)
    v_dot2c_f32_bf16 v76, v8, v8
    v_dot2c_f32_bf16 v77, v8, v78
    v_dot2c_f32_bf16 v76, v9, v9
    v_dot2c_f32_bf16 v77, v9, v78
    v_dot2c_f32_bf16 v76, v10, v10
    v_dot2c_f32_bf16 v77, v10, v78
    v_dot2c_f32_bf16 v76, v11, v11
    v_dot2c_f32_bf16 v77, v11, v78
    s_waitcnt lgkmcnt(3)
    v_dot2c_f32_bf16 v76, v12, v12
    v_dot2c_f32_bf16 v77, v12, v78
    v_dot2c_f32_bf16 v76, v13, v13
    v_dot2c_f32_bf16 v77, v13, v78
    v_dot2c_f32_bf16 v76, v14, v14
    v_dot2c_f32_bf16 v77, v14, v78
    v_dot2c_f32_bf16 v76, v15, v15
    v_dot2c_f32_bf16 v77, v15, v78
    s_waitcnt lgkmcnt(2)
    v_dot2c_f32_bf16 v76, v16, v16
    v_dot2c_f32_bf16 v77, v16, v78
    v_dot2c_f32_bf16 v76, v17, v17
    v_dot2c_f32_bf16 v77, v17, v78
    v_dot2c_f32_bf16 v76, v18, v18
    v_dot2c_f32_bf16 v77, v18, v78
    v_dot2c_f32_bf16 v76, v19, v19
    v_dot2c_f32_bf16 v77, v19, v78
    s_waitcnt lgkmcnt(1)
    v_dot2c_f32_bf16 v76, v20, v20
    v_dot2c_f32_bf16 v77, v20, v78
    v_dot2c_f32_bf16 v76, v21, v21
    v_dot2c_f32_bf16 v77, v21, v78
    v_dot2c_f32_bf16 v76, v22, v22
    v_dot2c_f32_bf16 v77, v22, v78
    v_dot2c_f32_bf16 v76, v23, v23
    v_dot2c_f32_bf16 v77, v23, v78
    s_waitcnt lgkmcnt(0)
    v_dot2c_f32_bf16 v76, v24, v24
    v_dot2c_f32_bf16 v77, v24, v78
    v_dot2c_f32_bf16 v76, v25, v25
    v_dot2c_f32_bf16 v77, v25, v78
    v_dot2c_f32_bf16 v76, v26, v26
    v_dot2c_f32_bf16 v77, v26, v78
    v_dot2c_f32_bf16 v76, v27, v27
    v_dot2c_f32_bf16 v77, v27, v78
    s_nop 1
    v_add_f32_dpp v76, v76, v76 quad_perm:[1,0,3,2] row_mask:0xf bank_mask:0xf
    v_add_f32_dpp v77, v77, v77 quad_perm:[1,0,3,2] row_mask:0xf bank_mask:0xf
    s_nop 0
    v_add_f32_dpp v76, v76, v76 quad_perm:[2,3,0,1] row_mask:0xf bank_mask:0xf
    v_add_f32_dpp v77, v77, v77 quad_perm:[2,3,0,1] row_mask:0xf bank_mask:0xf
    s_nop 0
    v_add_f32_dpp v76, v76, v76 row_half_mirror row_mask:0xf bank_mask:0xf
    v_add_f32_dpp v77, v77, v77 row_half_mirror row_mask:0xf bank_mask:0xf
    s_nop 0
    v_add_f32_dpp v76, v76, v76 row_mirror row_mask:0xf bank_mask:0xf
    v_add_f32_dpp v77, v77, v77 row_mirror row_mask:0xf bank_mask:0xf
    v_mul_f32 v77, 0x404ccccd, v77
    v_mul_f32 v76, 0x45cccccd, v76
    v_fma_f32 v76, -v77, v77, v76
    v_max_f32 v76, 0, v76
    v_add_f32 v76, 0x4227c5ac, v76
    v_rsq_f32 v76, v76
    s_nop 0
    v_bitop3_b32 v76, v76, s67, v6 bitop3:0xb8
    ds_bpermute_b32 v76, v89, v76
    s_barrier
    s_mov_b32 exec_hi, 0
    s_waitcnt lgkmcnt(0)
    buffer_store_dword v76, v88, s[8:11], s26 offen sc1
    s_mov_b64 exec, -1
    s_setprio 0
    v_mov_b32 v71, 1
    s_mov_b64 exec, 1
    s_waitcnt vmcnt(1)
    ds_add_u32 v125, v71 offset:22912
    s_mov_b64 exec, -1
    s_cmp_eq_u32 s24, 14
    s_cbranch_scc1 L_wsp
    s_branch L_s2done
L_s2other:
    s_setprio 0
    s_cmp_lt_u32 s24, 12
    s_cbranch_scc1 L_wsp
    v_mov_b32 v71, 1
    s_mov_b64 exec, 1
    s_waitcnt vmcnt(0)
    ds_add_u32 v125, v71 offset:22912
    s_mov_b64 exec, -1
L_wsp:
    ds_read_b32 v68, v125 offset:22912
    s_waitcnt lgkmcnt(0)
    v_cmp_gt_u32 vcc, 4, v68
    s_cbranch_vccnz L_wsp
L_wt:
    s_lshr_b32 s30, s57, 3
    s_add_u32 s30, s30, 2
    s_and_b32 s30, s30, 14
    s_add_u32 s30, s30, s59
    v_add_u32 v68, s30, v97
    v_add_u32 v69, s30, v90
    ds_read_u16 v8, v68 offset:0
    ds_read_u16 v9, v68 offset:512
    ds_read_u16 v10, v68 offset:3456
    ds_read_u16 v11, v68 offset:3968
    ds_read_u16 v12, v68 offset:6912
    ds_read_u16 v13, v68 offset:7424
    ds_read_u16 v14, v68 offset:10368
    ds_read_u16 v15, v68 offset:10880
    ds_read_u16 v16, v69 offset:0
    ds_read_u16 v17, v69 offset:512
    ds_read_u16 v18, v69 offset:3456
    ds_read_u16 v19, v69 offset:3968
    s_waitcnt lgkmcnt(10)
    ds_read_u16 v20, v69 offset:6912
    ds_read_u16 v21, v69 offset:7424
    ds_read_u16 v22, v69 offset:10368
    ds_read_u16 v23, v69 offset:10880
    s_mul_i32 s30, s57, 20608
    s_lshl_b32 s31, s50, 11
    s_add_u32 s30, s30, s31
    s_add_u32 s30, s30, 0x700000
    s_add_u32 s31, s30, 10240
    s_cmp_eq_u32 s28, 0
    s_waitcnt lgkmcnt(8)
    v_lshl_or_b32 v104, v9, 16, v8
    v_lshl_or_b32 v105, v11, 16, v10
    v_lshl_or_b32 v106, v13, 16, v12
    v_lshl_or_b32 v107, v15, 16, v14
    v_bitop3_b32 v104, v104, v7, v6 bitop3:0xb8
    v_bitop3_b32 v105, v105, v7, v6 bitop3:0xb8
    v_bitop3_b32 v106, v106, v7, v6 bitop3:0xb8
    v_bitop3_b32 v107, v107, v7, v6 bitop3:0xb8
    buffer_store_dwordx4 v[104:107], v98, s[8:11], s30 offen sc1
    s_waitcnt lgkmcnt(0)
    v_lshl_or_b32 v108, v17, 16, v16
    v_lshl_or_b32 v109, v19, 16, v18
    v_lshl_or_b32 v110, v21, 16, v20
    v_lshl_or_b32 v111, v23, 16, v22
    v_bitop3_b32 v108, v108, v7, v6 bitop3:0xb8
    v_bitop3_b32 v109, v109, v7, v6 bitop3:0xb8
    v_bitop3_b32 v110, v110, v7, v6 bitop3:0xb8
    v_bitop3_b32 v111, v111, v7, v6 bitop3:0xb8
    buffer_store_dwordx4 v[108:111], v98, s[8:11], s31 offen sc1
    s_cbranch_scc0 L_wtdone
L_s2done:
    s_setprio 0
    s_cmp_eq_u32 s3, 0
    s_cbranch_scc1 L_wtask
    s_mul_i32 s26, s32, 20
    s_add_u32 s26, s26, s34
    s_lshl_b32 s55, s26, 6
    v_lshrrev_b32 v98, 2, v1
    v_mul_u32_u24 v93, 10304, v98
    s_mul_i32 s33, s24, 165888
    s_add_u32 s33, s33, s55
    v_add_u32 v97, v93, v99
    s_add_u32 s33, s33, 0x400000
    v_and_b32 v90, 0x3f1, v0
    v_and_b32 v76, 2, v0
    v_lshl_add_u32 v90, v76, 2, v90
    v_and_b32 v76, 12, v0
    v_lshlrev_b32 v76, 2, v76
    v_lshl_add_u32 v90, v90, 3, v76
    s_lshr_b32 s30, s32, 2
    s_and_b32 s31, s32, 3
    s_lshl1_add_u32 s30, s31, s30
    s_lshl_b32 s30, s30, 13
    s_add_u32 s54, s30, 0x10000
    s_cmp_ge_u32 s24, 10
    s_cbranch_scc1 L_fok
L_pa:
    s_and_b32 s30, s24, 7
    v_cvt_f32_u32 v70, s30
    v_fmamk_f32 v69, v5, 0x42000000, v70
    v_mul_f32 v68, 0x3a000000, v4
    v_mul_f32 v69, v68, v69
    v_fmamk_f32 v49, v68, 0x41000000, v69
    v_fmamk_f32 v50, v68, 0x41800000, v69
    v_fmamk_f32 v51, v68, 0x41c00000, v69
    v_sin_f32 v52, v69
    v_sin_f32 v53, v49
    v_sin_f32 v54, v50
    v_sin_f32 v55, v51
    v_cos_f32 v48, v69
    v_cos_f32 v49, v49
    v_cos_f32 v50, v50
    v_cos_f32 v51, v51
    v_mul_f32 v69, 0x3e800000, v4
    v_mul_f32 v68, 0x3e800000, v69
    v_mul_f32 v69, v69, v5
    v_add_f32 v77, v68, v69
    v_fmamk_f32 v78, v68, 0x40000000, v69
    v_fmamk_f32 v79, v68, 0x40400000, v69
    v_sin_f32 v80, v69
    v_sin_f32 v81, v77
    v_sin_f32 v82, v78
    v_sin_f32 v83, v79
    v_cos_f32 v76, v69
    v_cos_f32 v77, v77
    v_cos_f32 v78, v78
    v_cos_f32 v79, v79
    v_cvt_pk_bf16_f32 v60, v80, v81
    v_cvt_pk_bf16_f32 v58, v76, v77
    v_xor_b32 v56, 0x80008000, v60
    v_cvt_pk_bf16_f32 v61, v82, v83
    v_cvt_pk_bf16_f32 v59, v78, v79
    v_xor_b32 v57, 0x80008000, v61
    v_lshrrev_b32 v73, 1, v2
    v_cvt_f32_u32 v73, v73
    v_fma_f32 v74, v73, -2.0, v4
    v_mul_f32 v74, 0x3e800000, v74
    v_cvt_f32_u32 v75, s24
    v_mul_f32 v68, 0x3c000000, v73
    v_fmamk_f32 v69, v5, 0x42000000, v75
    v_fma_f32 v76, v68, v69, v74
    v_fmamk_f32 v77, v68, 0x41800000, v76
    v_fmamk_f32 v68, v73, 0x41800000, v75
    v_mul_f32 v68, 0x3c800000, v68
    v_fma_f32 v78, v68, v5, -v74
    v_fma_f32 v79, v68, 0.5, v78
    v_sin_f32 v80, v76
    v_sin_f32 v81, v77
    v_sin_f32 v82, v78
    v_sin_f32 v83, v79
    v_cos_f32 v76, v76
    v_cos_f32 v77, v77
    v_cos_f32 v78, v78
    v_cos_f32 v79, v79
    s_cmp_eq_u32 s2, 104
    s_cselect_b64 s[30:31], s[62:63], 0
    v_cvt_pk_bf16_f32 v62, v76, v80
    v_cvt_pk_bf16_f32 v66, v78, -v82
    v_cndmask_b32 v64, v66, 0, s[30:31]
    v_cvt_pk_bf16_f32 v63, v77, v81
    v_cvt_pk_bf16_f32 v67, v79, -v83
    v_cndmask_b32 v65, v67, 0, s[30:31]
    s_cmp_ge_u32 s24, 10
    s_cbranch_scc1 L_pb
L_fok:
    s_setprio 2
    s_barrier
    buffer_load_dwordx4 v[16:19], v97, s[8:11], s33 offen sc1
    buffer_load_dwordx2 v[88:89], v90, s[8:11], s54 offen sc1
    s_setprio 0
    s_cbranch_scc1 L_pa
L_pb:
    v_mul_u32_u24 v98, 20544, v98
    v_add_u32 v99, v99, v98
    s_and_b32 s30, s24, 7
    s_mul_i32 s56, s30, 329728
    s_lshr_b32 s30, s24, 3
    s_lshl1_add_u32 s30, s26, s30
    s_lshl_b32 s30, s30, 6
    s_add_u32 s56, s56, s30
    s_add_u32 s56, s56, 0x700000
    s_andn2_b32 s64, s67, s27
    s_xor_b32 s64, s64, 0x2000
    v_lshlrev_b32 v76, 3, v3
    s_movk_i32 s31, 520
    v_mad_u32_u24 v76, v2, s31, v76
    s_lshl_b32 s30, s24, 5
    v_add_u32 v93, s30, v76
    v_lshl_add_u32 v95, v2, 9, v93
    v_add_u32 v95, s30, v95
    s_mul_i32 s30, s24, 1040
    v_lshl_add_u32 v94, v1, 3, s30
    s_mul_i32 s30, s24, 1032
    v_lshl_add_u32 v96, v1, 3, s30
    s_lshr_b32 s30, s24, 1
    v_lshl_add_u32 v91, s30, 2, v3
    v_lshl_add_u32 v91, v91, 8, s55
    s_add_u32 s31, s30, 32
    s_lshl_b32 s30, s30, 2
    s_cmp_lt_u32 s26, 128
    s_cselect_b32 s30, s30, s31
    s_cselect_b32 s31, 13, 11
    v_bfe_u32 v91, v91, 0, s31
    s_cselect_b32 s31, 14, 11
    v_lshl_add_u32 v91, v3, s31, v91
    v_lshl_add_u32 v91, v2, 2, v91
    s_and_b32 s31, s24, 1
    s_lshl1_add_u32 s30, s30, s31
    s_lshl_b32 s30, s30, 13
    s_add_u32 s55, s30, 0x200000
    v_lshlrev_b32 v92, 2, v1
    v_not_b32 v127, v6
    s_bfe_u32 s31, s2, 0x10002
    s_xor_b32 s18, s31, 13
    s_movk_i32 s57, 0x2000
    s_mov_b32 s65, 16
    s_setprio 1
L_xchk:
    s_waitcnt vmcnt(0)
    v_bitop3_b32 v12, v16, v6, v7 bitop3:0x78
    v_bitop3_b32 v13, v17, v6, v7 bitop3:0x78
    v_bitop3_b32 v14, v18, v6, v7 bitop3:0x78
    v_bitop3_b32 v15, v19, v6, v7 bitop3:0x78
    v_bitop3_b32 v76, v12, v13, v14 bitop3:0xfe
    v_bitop3_b32 v76, v76, v15, v7 bitop3:0xa8
    v_bitop3_b32 v77, v88, v89, v6 bitop3:0x7e
    v_and_or_b32 v76, v77, s67, v76
    v_cmp_ne_u32 vcc, 0, v76
    s_cbranch_vccz L_xok
    buffer_load_dwordx4 v[16:19], v97, s[8:11], s33 offen sc1
    buffer_load_dwordx2 v[88:89], v90, s[8:11], s54 offen sc1
    s_add_u32 s29, s29, 1
    s_cmp_lt_u32 s29, 0x20000
    s_cbranch_scc1 L_xchk
    s_waitcnt vmcnt(0)
L_xok:
    buffer_store_dword v127, v91, s[8:11], s55 offen sc1
    buffer_load_dwordx4 v[100:103], v99, s[8:11], s56 offen sc1
    buffer_load_dword v124, v92, s[8:11], s57 offen sc1
    s_movk_i32 s30, 0x7fff
    v_lshl_or_b32 v8, v12, 16, s30
    v_lshl_or_b32 v9, v13, 16, s30
    v_lshl_or_b32 v10, v14, 16, s30
    v_lshl_or_b32 v11, v15, 16, s30
    s_branch L_havex
L_layer:
    buffer_load_dwordx2 v[88:89], v90, s[8:11], s54 offen sc1
    s_waitcnt vmcnt(0)
    v_bitop3_b32 v76, v88, v89, v6 bitop3:0x7e
    v_and_b32 v76, 0x3fff, v76
    v_cmp_ne_u32 vcc, 0, v76
    s_cbranch_vccz L_sok
    s_add_u32 s29, s29, 1
    s_cmp_lt_u32 s29, 0x20000
    s_cbranch_scc1 L_layer
L_sok:
L_havex:
    v_xor_b32 v88, s64, v88
    v_xor_b32 v89, s64, v89
    v_mul_f32 v76, v88, v8
    v_mul_f32 v77, v88, v9
    v_mul_f32 v78, v89, v10
    v_mul_f32 v79, v89, v11
    v_mul_f32 v80, v88, v12
    v_mul_f32 v81, v88, v13
    v_mul_f32 v82, v89, v14
    v_mul_f32 v83, v89, v15
    v_cvt_pk_bf16_f32 v84, v76, v77
    v_cvt_pk_bf16_f32 v85, v78, v79
    v_cvt_pk_bf16_f32 v86, v80, v81
    v_cvt_pk_bf16_f32 v87, v82, v83
    v_mfma_f32_16x16x16_bf16 v[68:71], v[84:85], v[62:63], 0
    s_cmp_lg_u32 s28, 1
    v_mfma_f32_16x16x16_bf16 v[72:75], v[86:87], v[62:63], 0
    s_nop 5
    v_cvt_pk_bf16_f32 v84, v68, v69
    v_cvt_pk_bf16_f32 v85, v70, v71
    ds_write_b64 v93, v[84:85] offset:22976
    v_cvt_pk_bf16_f32 v86, v72, v73
    v_cvt_pk_bf16_f32 v87, v74, v75
    ds_write_b64 v93, v[86:87] offset:31296
    s_waitcnt lgkmcnt(0)
    s_barrier
    ds_read_b64_tr_b16 v[84:85], v94 offset:22976
    ds_read_b64_tr_b16 v[86:87], v94 offset:23496
    s_cbranch_scc1 L_nowb
    buffer_load_dwordx4 v[100:103], v99, s[8:11], s56 offen sc1
L_nowb:
    s_waitcnt lgkmcnt(0)
    v_mfma_f32_16x16x32_bf16 v[68:71], v[84:87], v[58:61], 0
    v_mfma_f32_16x16x32_bf16 v[72:75], v[84:87], v[56:59], 0
    s_nop 6
    v_mul_f32 v76, v40, v68
    v_mul_f32 v77, v41, v69
    v_mul_f32 v78, v42, v70
    v_mul_f32 v79, v43, v71
    v_mul_f32 v80, -v44, v68
    v_mul_f32 v81, -v45, v69
    v_mul_f32 v82, -v46, v70
    v_mul_f32 v83, -v47, v71
    v_fmac_f32 v76, v44, v72
    v_fmac_f32 v77, v45, v73
    v_fmac_f32 v78, v46, v74
    v_fmac_f32 v79, v47, v75
    v_fmac_f32 v80, v40, v72
    v_fmac_f32 v81, v41, v73
    v_fmac_f32 v82, v42, v74
    v_fmac_f32 v83, v43, v75
    v_cvt_pk_bf16_f32 v84, v76, v77
    v_cvt_pk_bf16_f32 v85, v78, v79
    v_cvt_pk_bf16_f32 v86, v80, v81
    v_cvt_pk_bf16_f32 v87, v82, v83
    s_cmp_lt_u32 s28, 2
    s_nop 0
    v_mfma_f32_16x16x32_bf16 v[68:71], v[58:61], v[84:87], 0
    v_mfma_f32_16x16x32_bf16 v[72:75], v[56:59], v[84:87], 0
    s_cbranch_scc1 L_wpoll
    s_cmp_eq_u32 s28, 3
    s_cbranch_scc1 L_nopre
L_pre1:
    buffer_store_dword v127, v91, s[8:11], s55 offen sc1
    s_cmp_lg_u32 s24, s18
    s_cbranch_scc1 L_nopre
L_pre2:
    v_mov_b32 v100, v127
    v_mov_b32 v101, v127
    v_mov_b32 v102, v127
    v_mov_b32 v103, v127
    buffer_store_dwordx4 v[100:103], v98, s[8:11], s58 offen sc1
L_nopre:
    s_nop 3
    v_mul_f32 v76, v24, v68
    v_mul_f32 v77, v25, v69
    v_mul_f32 v78, v26, v70
    v_mul_f32 v79, v27, v71
    v_mul_f32 v80, v28, v68
    v_mul_f32 v81, v29, v69
    v_mul_f32 v82, v30, v70
    v_mul_f32 v83, v31, v71
    v_fma_f32 v76, -v28, v72, v76
    v_fma_f32 v77, -v29, v73, v77
    v_fma_f32 v78, -v30, v74, v78
    v_fma_f32 v79, -v31, v75, v79
    v_fmac_f32 v80, v24, v72
    v_fmac_f32 v81, v25, v73
    v_fmac_f32 v82, v26, v74
    v_fmac_f32 v83, v27, v75
    v_cvt_pk_bf16_f32 v84, v80, v81
    v_cvt_pk_bf16_f32 v85, v82, v83
    v_cvt_pk_bf16_f32 v86, v76, v77
    v_cvt_pk_bf16_f32 v87, v78, v79
    s_nop 1
    v_mfma_f32_16x16x32_bf16 v[68:71], v[84:87], v[56:59], 0
    v_mfma_f32_16x16x32_bf16 v[72:75], v[84:87], v[58:61], 0
    s_nop 6
    v_mul_f32 v76, v48, v68
    v_mul_f32 v77, v49, v69
    v_mul_f32 v78, v50, v70
    v_mul_f32 v79, v51, v71
    v_mul_f32 v80, v52, v68
    v_mul_f32 v81, v53, v69
    v_mul_f32 v82, v54, v70
    v_mul_f32 v83, v55, v71
    v_fma_f32 v76, -v52, v72, v76
    v_fma_f32 v77, -v53, v73, v77
    v_fma_f32 v78, -v54, v74, v78
    v_fma_f32 v79, -v55, v75, v79
    v_fmac_f32 v80, v48, v72
    v_fmac_f32 v81, v49, v73
    v_fmac_f32 v82, v50, v74
    v_fmac_f32 v83, v51, v75
    v_cvt_pk_bf16_f32 v84, v80, v81
    v_cvt_pk_bf16_f32 v85, v82, v83
    v_cvt_pk_bf16_f32 v86, v76, v77
    v_cvt_pk_bf16_f32 v87, v78, v79
    s_nop 1
    v_mfma_f32_16x16x32_bf16 v[68:71], v[84:87], v[56:59], 0
    v_mfma_f32_16x16x32_bf16 v[72:75], v[84:87], v[58:61], 0
    s_cmp_eq_u32 s28, 3
    s_setprio 1
    s_nop 4
    v_cvt_pk_bf16_f32 v84, v68, v69
    v_cvt_pk_bf16_f32 v85, v70, v71
    ds_write_b64 v95, v[84:85] offset:39616
    v_cvt_pk_bf16_f32 v86, v72, v73
    v_cvt_pk_bf16_f32 v87, v74, v75
    ds_write_b64 v95, v[86:87] offset:39648
    s_waitcnt lgkmcnt(0)
    s_barrier
    ds_read_b64_tr_b16 v[84:85], v96 offset:39616
    ds_read_b64_tr_b16 v[86:87], v96 offset:40128
    s_waitcnt lgkmcnt(1)
    v_mfma_f32_16x16x16_bf16 v[8:11], v[64:65], v[84:85], v[8:11]
    s_waitcnt lgkmcnt(0)
    v_mfma_f32_16x16x16_bf16 v[12:15], v[66:67], v[86:87], v[12:15]
    s_cbranch_scc1 L_delta
    s_nop 4
    v_mul_f32 v76, v8, v8
    v_mul_f32 v77, v10, v10
    v_fmac_f32 v76, v9, v9
    v_fmac_f32 v77, v11, v11
    v_fmac_f32 v76, v12, v12
    v_fmac_f32 v77, v14, v14
    v_fmac_f32 v76, v13, v13
    v_fmac_f32 v77, v15, v15
    v_cvt_pk_bf16_f32 v76, v76, v77
    v_bitop3_b32 v76, v76, s66, v6 bitop3:0xb8
    buffer_store_dword v76, v91, s[8:11], s55 offen sc1
    s_setprio 0
    s_cmp_eq_u32 s28, 1
    s_cbranch_scc1 L_sh1
    s_cmp_eq_u32 s28, 2
    s_cbranch_scc1 L_sh2
    s_branch L_sh0
L_shret:
    s_cmp_lg_u32 s24, s18
    s_cbranch_scc1 L_sskip
    s_setprio 3
    v_mov_b32 v125, 0x4227c5ac
    s_mov_b32 s31, 0x41a3d70a
    s_waitcnt vmcnt(0)
L_ppoll:
    buffer_load_dwordx4 v[72:75], v97, s[8:11], s59 offen sc1
    buffer_load_dwordx4 v[76:79], v97, s[8:11], s59 offen offset:1024 sc1
    buffer_load_dwordx4 v[80:83], v97, s[8:11], s59 offen offset:2048 sc1
    buffer_load_dwordx4 v[84:87], v97, s[8:11], s59 offen offset:3072 sc1
    buffer_load_dwordx4 v[100:103], v97, s[8:11], s16 offen sc1
    buffer_load_dwordx4 v[104:107], v97, s[8:11], s16 offen offset:1024 sc1
    buffer_load_dwordx4 v[108:111], v97, s[8:11], s16 offen offset:2048 sc1
    buffer_load_dwordx4 v[112:115], v97, s[8:11], s16 offen offset:3072 sc1
    buffer_load_dwordx4 v[116:119], v97, s[8:11], s17 offen sc1
    buffer_load_dwordx4 v[120:123], v97, s[8:11], s17 offen offset:1024 sc1
    s_waitcnt vmcnt(9)
    v_mfma_f32_16x16x32_bf16 v[68:71], v[20:23], v[72:75], 0
    v_bitop3_b32 v89, v72, v73, v6 bitop3:0x7e
    v_bitop3_b32 v124, v74, v75, v6 bitop3:0x7e
    v_or_b32 v88, v89, v124
    s_waitcnt vmcnt(8)
    v_mfma_f32_16x16x32_bf16 v[68:71], v[20:23], v[76:79], v[68:71]
    v_bitop3_b32 v89, v76, v77, v6 bitop3:0x7e
    v_bitop3_b32 v124, v78, v79, v6 bitop3:0x7e
    v_bitop3_b32 v88, v88, v89, v124 bitop3:0xfe
    s_waitcnt vmcnt(7)
    v_mfma_f32_16x16x32_bf16 v[68:71], v[20:23], v[80:83], v[68:71]
    v_bitop3_b32 v89, v80, v81, v6 bitop3:0x7e
    v_bitop3_b32 v124, v82, v83, v6 bitop3:0x7e
    v_bitop3_b32 v88, v88, v89, v124 bitop3:0xfe
    s_waitcnt vmcnt(6)
    v_mfma_f32_16x16x32_bf16 v[68:71], v[20:23], v[84:87], v[68:71]
    v_bitop3_b32 v89, v84, v85, v6 bitop3:0x7e
    v_bitop3_b32 v124, v86, v87, v6 bitop3:0x7e
    v_bitop3_b32 v88, v88, v89, v124 bitop3:0xfe
    s_waitcnt vmcnt(5)
    v_mfma_f32_16x16x32_bf16 v[68:71], v[20:23], v[100:103], v[68:71]
    v_bitop3_b32 v89, v100, v101, v6 bitop3:0x7e
    v_bitop3_b32 v124, v102, v103, v6 bitop3:0x7e
    v_bitop3_b32 v88, v88, v89, v124 bitop3:0xfe
    s_waitcnt vmcnt(4)
    v_mfma_f32_16x16x32_bf16 v[68:71], v[20:23], v[104:107], v[68:71]
    v_bitop3_b32 v89, v104, v105, v6 bitop3:0x7e
    v_bitop3_b32 v124, v106, v107, v6 bitop3:0x7e
    v_bitop3_b32 v88, v88, v89, v124 bitop3:0xfe
    s_waitcnt vmcnt(3)
    v_mfma_f32_16x16x32_bf16 v[68:71], v[20:23], v[108:111], v[68:71]
    v_bitop3_b32 v89, v108, v109, v6 bitop3:0x7e
    v_bitop3_b32 v124, v110, v111, v6 bitop3:0x7e
    v_bitop3_b32 v88, v88, v89, v124 bitop3:0xfe
    s_waitcnt vmcnt(2)
    v_mfma_f32_16x16x32_bf16 v[68:71], v[20:23], v[112:115], v[68:71]
    v_bitop3_b32 v89, v112, v113, v6 bitop3:0x7e
    v_bitop3_b32 v124, v114, v115, v6 bitop3:0x7e
    v_bitop3_b32 v88, v88, v89, v124 bitop3:0xfe
    s_waitcnt vmcnt(1)
    v_mfma_f32_16x16x32_bf16 v[68:71], v[20:23], v[116:119], v[68:71]
    v_bitop3_b32 v89, v116, v117, v6 bitop3:0x7e
    v_bitop3_b32 v124, v118, v119, v6 bitop3:0x7e
    v_bitop3_b32 v88, v88, v89, v124 bitop3:0xfe
    s_waitcnt vmcnt(0)
    v_mfma_f32_16x16x32_bf16 v[68:71], v[20:23], v[120:123], v[68:71]
    v_bitop3_b32 v89, v120, v121, v6 bitop3:0x7e
    v_bitop3_b32 v124, v122, v123, v6 bitop3:0x7e
    v_bitop3_b32 v88, v88, v89, v124 bitop3:0xfe
    v_and_b32 v88, s66, v88
    v_cmp_ne_u32 vcc, 0, v88
    s_cbranch_vccz L_pok
    s_add_u32 s29, s29, 1
    s_cmp_lt_u32 s29, 0x20000
    s_cbranch_scc1 L_ppoll
L_pok:
    s_nop 1
    v_add_f32_dpp v68, v68, v68 row_ror:8 row_mask:0xf bank_mask:0xf
    v_add_f32_dpp v69, v69, v69 row_ror:8 row_mask:0xf bank_mask:0xf
    v_add_f32_dpp v70, v70, v70 row_ror:8 row_mask:0xf bank_mask:0xf
    v_add_f32_dpp v71, v71, v71 row_ror:8 row_mask:0xf bank_mask:0xf
    v_add_f32_dpp v68, v68, v68 row_ror:4 row_mask:0xf bank_mask:0xf
    v_add_f32_dpp v69, v69, v69 row_ror:4 row_mask:0xf bank_mask:0xf
    v_add_f32_dpp v70, v70, v70 row_ror:4 row_mask:0xf bank_mask:0xf
    v_add_f32_dpp v71, v71, v71 row_ror:4 row_mask:0xf bank_mask:0xf
    v_fma_f32 v68, |v68|, s31, v125
    v_fma_f32 v69, |v69|, s31, v125
    v_fma_f32 v70, |v70|, s31, v125
    v_fma_f32 v71, |v71|, s31, v125
    v_rsq_f32 v68, v68
    v_rsq_f32 v69, v69
    v_rsq_f32 v70, v70
    v_rsq_f32 v71, v71
    v_bitop3_b32 v68, v68, s67, v6 bitop3:0xb8
    v_bitop3_b32 v69, v69, s67, v6 bitop3:0xb8
    v_bitop3_b32 v70, v70, s67, v6 bitop3:0xb8
    v_bitop3_b32 v71, v71, s67, v6 bitop3:0xb8
    s_mov_b64 exec, s[20:21]
    buffer_store_dwordx4 v[68:71], v98, s[8:11], s58 offen sc1
    s_not_b64 exec, exec
    buffer_store_dwordx4 v[68:71], v98, s[8:11], s58 offen sc1
    s_mov_b64 exec, -1
    v_add_u32 v97, 655360, v97
    s_add_u32 s58, s58, 0x20000
    s_setprio 0
L_sskip:
    s_add_u32 s28, s28, 1
    s_add_u32 s54, s54, 0x20000
    s_add_u32 s55, s55, 655360
    s_waitcnt vmcnt(1)
    s_barrier
    s_branch L_layer
L_wpoll:
    s_waitcnt vmcnt(0)
    v_bitop3_b32 v25, v100, v6, v7 bitop3:0x78
    v_bitop3_b32 v27, v101, v6, v7 bitop3:0x78
    v_bitop3_b32 v29, v102, v6, v7 bitop3:0x78
    v_bitop3_b32 v31, v103, v6, v7 bitop3:0x78
    v_bitop3_b32 v76, v25, v27, v29 bitop3:0xfe
    v_bitop3_b32 v76, v76, v31, v7 bitop3:0xa8
    v_cmp_ne_u32 vcc, 0, v76
    s_cbranch_vccz L_wok
    buffer_load_dwordx4 v[100:103], v99, s[8:11], s56 offen sc1
    s_add_u32 s29, s29, 1
    s_cmp_lt_u32 s29, 0x20000
    s_cbranch_scc1 L_wpoll
    s_waitcnt vmcnt(0)
L_wok:
    s_movk_i32 s30, 0x7fff
    v_lshl_or_b32 v24, v25, 16, s30
    v_lshl_or_b32 v26, v27, 16, s30
    v_lshl_or_b32 v28, v29, 16, s30
    v_lshl_or_b32 v30, v31, 16, s30
    s_cmp_lg_u32 s28, 0
    s_cbranch_scc1 L_pre1
L_vp:
    v_xor_b32 v76, v124, v6
    v_cmp_lt_u32 vcc, 1, v76
    s_cbranch_vccz L_vok
    buffer_load_dword v124, v92, s[8:11], s57 offen sc1
    s_waitcnt vmcnt(0)
    s_add_u32 s29, s29, 1
    s_cmp_lt_u32 s29, 0x20000
    s_cbranch_scc1 L_vp
L_vok:
    v_and_b32 v76, 1, v124
    v_cmp_ne_u32 vcc, 0, v76
    s_nop 0
    s_bcnt1_i32_b32 s30, vcc_lo
    s_cmp_gt_u32 s30, 16
    s_cselect_b32 s58, 0x2000, 0
    s_xor_b32 s54, s54, s58
    s_bcnt1_i32_b32 s30, vcc_hi
    s_cmp_gt_u32 s30, 16
    s_cselect_b32 s30, 0x2000, 0
    s_xor_b32 s55, s55, s30
    s_cmp_lg_u32 s24, s18
    s_cbranch_scc1 L_nopre
    s_and_b32 s31, s2, 4
    s_cselect_b32 s20, 0, -1
    s_cselect_b32 s21, -1, 0
    s_lshl_b32 s31, s31, 11
    s_xor_b32 s30, s30, s31
    s_add_u32 s30, s30, 0x200000
    s_bfe_u32 s31, s2, 0x30003
    s_and_b32 s16, s2, 3
    s_lshl2_add_u32 s59, s31, s16
    s_lshl_b32 s59, s59, 14
    s_add_u32 s59, s59, s30
    s_lshl3_add_u32 s31, s31, s16
    s_lshl_b32 s31, s31, 11
    s_add_u32 s31, s31, s30
    s_add_u32 s17, s31, 0x80000
    s_add_u32 s16, s59, 4096
    v_lshlrev_b32 v97, 4, v1
    v_and_b32 v76, 12, v1
    v_lshlrev_b32 v76, 12, v76
    v_and_b32 v77, 32, v1
    v_lshl_add_u32 v76, v77, 8, v76
    v_and_b32 v77, 16, v1
    v_lshl_add_u32 v76, v77, 2, v76
    v_and_or_b32 v76, v97, 48, v76
    v_xor_b32 v98, s58, v76
    s_and_b32 s30, s2, 63
    s_lshl_b32 s30, s30, 7
    s_cmp_ge_u32 s2, 64
    s_cselect_b32 s31, 0x10000, 0
    s_add_u32 s30, s30, s31
    s_add_u32 s58, s30, 0x30000
    s_branch L_pre2
L_wtask:
    s_barrier
    s_mov_b32 s28, 1
    s_cmp_ge_u32 s24, 5
    s_cselect_b32 s30, 5, 0
    s_sub_u32 s30, s24, s30
    s_cmp_lt_u32 s24, 10
    s_cselect_b32 s50, s30, s50
    s_cbranch_scc1 L_wk1
    s_cmp_lt_u32 s24, 12
    s_cbranch_scc1 L_wb3
    s_mov_b64 s[16:17], s[44:45]
    s_mov_b32 s18, 0x141000
    s_mov_b32 s19, 0x00020000
    s_mov_b64 s[20:21], s[46:47]
    s_mov_b32 s22, 0x141000
    s_mov_b32 s23, 0x00020000
    s_mov_b32 exec_lo, 0x1fffff
    s_mov_b32 exec_hi, exec_lo
    s_sub_u32 s57, s57, 80
L_wb2:
    s_add_u32 s58, s58, 13824
    s_lshr_b32 s30, s57, 4
    s_and_b32 s31, s57, 3
    s_lshl2_add_u32 s31, s31, s33
    s_lshl3_add_u32 s30, s31, s30
    s_and_b32 s31, s57, 12
    s_lshl_b32 s31, s31, 7
    s_add_u32 s30, s30, s31
    s_mul_i32 s30, s30, 642
    s_add_u32 s30, s30, s65
    s_and_b32 s30, s30, 0xfffffff0
    s_add_u32 s31, s30, 164352
    s_add_u32 m0, s58, 0
    s_nop 0
    buffer_load_dwordx4 v92, s[16:19], s30 offen nt lds
    s_add_u32 m0, s58, 3456
    s_nop 0
    buffer_load_dwordx4 v92, s[16:19], s31 offen nt lds
    s_add_u32 m0, s58, 6912
    s_nop 0
    buffer_load_dwordx4 v92, s[20:23], s30 offen nt lds
    s_add_u32 m0, s58, 10368
    s_nop 0
    buffer_load_dwordx4 v92, s[20:23], s31 offen nt lds
    s_add_u32 s57, s57, 48
    s_cmp_lt_u32 s57, 128
    s_cbranch_scc1 L_wb2
    s_mov_b64 exec, -1
    s_waitcnt vmcnt(0)
L_wb3:
    s_sub_u32 s30, s24, s50
    s_add_u32 s30, s30, 5
    s_mul_i32 s30, s30, 52
    s_lshr_b32 s30, s30, 8
    s_mul_i32 s59, s30, 13824
    s_add_u32 s59, s59, 39616
    s_mul_i32 s30, s30, 48
    s_lshr_b32 s57, s2, 1
    s_add_u32 s57, s57, s30
    s_cmp_eq_u32 s24, 15
    s_cselect_b32 s57, 256, s57
    s_cmp_lt_u32 s57, 256
    s_waitcnt lgkmcnt(0)
    s_barrier
    s_cbranch_scc1 L_wt
L_wtdone:
    s_branch L_fc0
L_sh0:
    s_add_u32 s56, s56, 2637824
    v_mov_b32 v32, v24
    v_mov_b32 v33, v25
    v_mov_b32 v34, v26
    v_mov_b32 v35, v27
    v_mov_b32 v36, v28
    v_mov_b32 v37, v29
    v_mov_b32 v38, v30
    v_mov_b32 v39, v31
    v_mov_b32 v76, 0x3f80
    v_cndmask_b32 v76, v76, 1.0, s[62:63]
    s_mov_b32 s30, 0x03030303
    s_mov_b32 s31, s30
    v_cndmask_b32 v20, 0, v76, s[30:31]
    s_lshl_b32 s30, s30, 2
    s_mov_b32 s31, s30
    v_cndmask_b32 v21, 0, v76, s[30:31]
    s_lshl_b32 s30, s30, 2
    s_mov_b32 s31, s30
    v_cndmask_b32 v22, 0, v76, s[30:31]
    s_lshl_b32 s30, s30, 2
    s_mov_b32 s31, s30
    v_cndmask_b32 v23, 0, v76, s[30:31]
L_fc0:
    s_cmp_ge_u32 s24, 12
    s_cbranch_scc1 L_fc0e
    s_and_b32 s30, s24, 12
    v_cvt_f32_u32 v68, s30
    v_fma_f32 v68, v68, 4.0, v4
    v_mul_f32 v68, 0x3ccccccd, v68
    v_add_f32 v69, v5, v5
    v_mul_f32 v70, v68, v69
    v_add_f32 v69, v70, v70
    v_add_f32 v77, v68, v69
    v_fmamk_f32 v78, v68, 0x40000000, v69
    v_fmamk_f32 v79, v68, 0x40400000, v69
    v_sin_f32 v80, v69
    v_sin_f32 v81, v77
    v_sin_f32 v82, v78
    v_sin_f32 v83, v79
    v_cos_f32 v76, v69
    v_cos_f32 v77, v77
    v_cos_f32 v78, v78
    v_cos_f32 v79, v79
    v_fmamk_f32 v84, v68, 0x41800000, v70
    v_fmamk_f32 v85, v68, 0x41880000, v70
    v_sin_f32 v86, v84
    v_sin_f32 v87, v85
    v_cos_f32 v84, v84
    v_cos_f32 v85, v85
    v_cndmask_b32 v69, -1.0, 1.0, s[62:63]
    s_bfm_b64 s[30:31], 16, 0
    v_cndmask_b32 v80, v80, v69, s[30:31]
    v_cvt_pk_bf16_f32 v116, v76, -v80
    v_cvt_pk_bf16_f32 v117, v77, -v81
    v_cvt_pk_bf16_f32 v118, v78, -v82
    v_cvt_pk_bf16_f32 v119, v79, -v83
    v_cvt_pk_bf16_f32 v122, v84, -v86
    v_cndmask_b32 v122, v122, 0, s[60:61]
    v_mov_b32 v120, 0
    v_cvt_pk_bf16_f32 v123, v85, -v87
    v_cndmask_b32 v123, v123, 0, s[60:61]
    v_mov_b32 v121, 0
L_fc0e:
    s_cmp_eq_u32 s3, 1
    s_cbranch_scc1 L_shret
    s_branch L_fc1
L_sh1:
    v_swap_b32 v24, v32
    v_swap_b32 v25, v33
    v_swap_b32 v26, v34
    v_swap_b32 v27, v35
    v_swap_b32 v28, v36
    v_swap_b32 v29, v37
    v_swap_b32 v30, v38
    v_swap_b32 v31, v39
L_fc1:
    s_cmp_ge_u32 s24, 10
    s_cbranch_scc1 L_fc1e
    v_mul_f32 v68, 0x3b4ccccd, v4
    v_cvt_f32_u32 v69, s24
    v_fmamk_f32 v69, v5, 0x42a00000, v69
    v_mul_f32 v69, v68, v69
    v_fmamk_f32 v76, v68, 0x3f000000, v69
    v_fmamk_f32 v77, v68, 0x41a40000, v69
    v_fmamk_f32 v78, v68, 0x42220000, v69
    v_fmamk_f32 v79, v68, 0x42720000, v69
    v_sin_f32 v80, v76
    v_sin_f32 v81, v77
    v_sin_f32 v82, v78
    v_sin_f32 v83, v79
    v_cos_f32 v76, v76
    v_cos_f32 v77, v77
    v_cos_f32 v78, v78
    v_cos_f32 v79, v79
    v_cvt_pk_bf16_f32 v108, 0, v76
    v_cvt_pk_bf16_f32 v109, 0, v77
    v_cvt_pk_bf16_f32 v110, 0, v78
    v_cvt_pk_bf16_f32 v111, 0, v79
    v_cvt_pk_bf16_f32 v112, 0, v80
    v_cvt_pk_bf16_f32 v113, 0, v81
    v_cvt_pk_bf16_f32 v114, 0, v82
    v_cvt_pk_bf16_f32 v115, 0, v83
    v_not_b32 v124, v7
    v_mov_b32 v125, v124
    s_cmp_lg_u32 s24, 0
    s_cbranch_scc1 L_fcn
    v_mov_b32 v76, 0x3e800000
    v_fmamk_f32 v76, v68, 0x41200000, v76
    v_mul_f32 v77, 0x41a00000, v68
    v_cndmask_b32 v76, v77, v76, s[60:61]
    v_add_f32 v69, v69, v76
    s_xor_b64 s[30:31], s[60:61], s[62:63]
    v_mov_b32 v76, 0xfffe0000
    v_cndmask_b32 v125, v76, v125, s[30:31]
    v_cndmask_b32 v124, v124, v76, s[30:31]
L_fcn:
    v_fmamk_f32 v77, v68, 0x41a00000, v69
    v_fmamk_f32 v78, v68, 0x42200000, v69
    v_fmamk_f32 v79, v68, 0x42700000, v69
    v_sin_f32 v80, v69
    v_sin_f32 v81, v77
    v_sin_f32 v82, v78
    v_sin_f32 v83, v79
    v_cos_f32 v76, v69
    v_cos_f32 v77, v77
    v_cos_f32 v78, v78
    v_cos_f32 v79, v79
    s_cmp_eq_u32 s24, 0
    s_cselect_b32 s30, 0xffff0000, 0
    s_mov_b32 s31, 0
    v_mul_f32 v70, 0x3f3504f3, v79
    v_cndmask_b32 v79, v79, v70, s[30:31]
    v_cvt_pk_bf16_f32 v100, v76, 0
    v_cvt_pk_bf16_f32 v101, v77, 0
    v_cvt_pk_bf16_f32 v102, v78, 0
    v_cvt_pk_bf16_f32 v103, v79, 0
    v_cvt_pk_bf16_f32 v104, v80, 0
    v_cvt_pk_bf16_f32 v105, v81, 0
    v_cvt_pk_bf16_f32 v106, v82, 0
    v_cvt_pk_bf16_f32 v107, v83, 0
L_fc1e:
    s_cmp_eq_u32 s3, 1
    s_cbranch_scc1 L_shret
    s_branch L_fc2
L_sh2:
    v_mov_b32 v24, v32
    v_mov_b32 v25, v33
    v_mov_b32 v26, v34
    v_mov_b32 v27, v35
    v_mov_b32 v28, v36
    v_mov_b32 v29, v37
    v_mov_b32 v30, v38
    v_mov_b32 v31, v39
    v_bitop3_b32 v36, v16, v6, v7 bitop3:0x78
    v_bitop3_b32 v37, v17, v6, v7 bitop3:0x78
    v_bitop3_b32 v38, v18, v6, v7 bitop3:0x78
    v_bitop3_b32 v39, v19, v6, v7 bitop3:0x78
    s_movk_i32 s30, 0x7fff
    v_lshl_or_b32 v32, v36, 16, s30
    v_lshl_or_b32 v33, v37, 16, s30
    v_lshl_or_b32 v34, v38, 16, s30
    v_lshl_or_b32 v35, v39, 16, s30
    s_and_b32 s30, s26, 1
    s_lshl4_add_u32 s31, s24, s30
    s_mul_i32 s31, s31, 10368
    s_sub_u32 s30, s26, s30
    s_lshl_b32 s30, s30, 6
    s_add_u32 s30, s30, s31
    s_add_u32 s56, s30, 0x400000
    s_cmp_lt_u32 s2, 96
    s_cselect_b32 s65, 12, 16
    s_lshl_b32 s50, s2, 7
    s_add_u32 s50, s50, 0x4000
    v_lshrrev_b32 v99, 3, v1
    v_mul_u32_u24 v99, 20608, v99
    v_lshl_add_u32 v99, v1, 4, v99
L_fc2:
    v_xor_b32 v127, 1, v6
    s_cmp_ge_u32 s24, 12
    s_cbranch_scc1 L_fc2e
    s_and_b32 s30, s25, 1
    s_sub_u32 s31, s25, s30
    s_mul_i32 s31, s31, 10368
    s_lshl4_add_u32 s30, s24, s30
    s_lshl_b32 s30, s30, 6
    s_add_u32 s30, s30, s31
    s_add_u32 s33, s30, 0x400000
    v_and_b32 v22, 1, v3
    v_mul_u32_u24 v92, 10304, v22
    v_lshl_add_u32 v92, v1, 2, v92
    s_and_b32 s30, s25, 12
    s_lshl_b32 s30, s30, 7
    s_and_b32 s31, s25, 0xf0
    s_add_u32 s30, s30, s31
    s_and_b32 s31, s25, 3
    s_lshl2_add_u32 s30, s31, s30
    s_mul_i32 s35, s30, 1280
    v_mul_u32_u24 v21, 80, v2
    v_mul_u32_u24 v20, 2560, v3
    s_lshl_b32 s30, s24, 3
    v_add3_u32 v20, v20, v21, s30
    s_and_b32 s31, s24, 3
    s_mul_i32 s30, s31, 2560
    v_add_u32 v21, s30, v21
    v_lshl_add_u32 v22, v22, 3, v21
    v_lshl_add_u32 v21, v3, 4, v21
    s_and_b32 s30, s24, 12
    v_lshl_add_u32 v23, s30, 2, v2
    v_min_u32 v23, 39, v23
    v_lshl_add_u32 v23, v23, 2, v3
    s_mul_i32 s30, s31, 1280
    v_lshl_add_u32 v23, v23, 3, s30
    ds_read_b64 v[16:17], v23
    ds_read_b64 v[18:19], v23 offset:5120
    s_cmp_ge_u32 s24, 8
    s_cselect_b32 s60, 0x00ff00ff, -1
    s_mov_b32 s61, s60
    s_add_u32 s57, s35, 327680
    v_and_b32 v76, 1, v3
    s_mov_b32 s30, 327672
    v_mad_u32_u24 v23, v76, s30, v23
    s_waitcnt lgkmcnt(0)
L_fc2e:
    s_cmp_eq_u32 s3, 1
    s_cbranch_scc1 L_shret
    s_and_b32 s30, s34, 7
    s_cmp_lg_u32 s24, s30
    s_cbranch_scc1 L_final
    s_bfm_b64 exec, 16, 0
L_canary:
    buffer_load_dword v76, v92, s[8:11], s33 offen sc1
    s_waitcnt vmcnt(0)
    v_bitop3_b32 v76, v76, v127, v7 bitop3:0x28
    v_cmp_ne_u32 vcc, 0, v76
    s_cbranch_vccz L_cok
    s_add_u32 s29, s29, 1
    s_cmp_lt_u32 s29, 0x20000
    s_cbranch_scc1 L_canary
L_cok:
    s_mov_b64 exec, -1
    s_branch L_final
L_delta:
    s_nop 4
    v_sub_f32 v76, v8, v32
    v_sub_f32 v77, v9, v33
    v_sub_f32 v78, v10, v34
    v_sub_f32 v79, v11, v35
    v_sub_f32 v80, v12, v36
    v_sub_f32 v81, v13, v37
    v_sub_f32 v82, v14, v38
    v_sub_f32 v83, v15, v39
    v_cvt_pk_bf16_f32 v84, v76, v80
    v_cvt_pk_bf16_f32 v85, v77, v81
    v_cvt_pk_bf16_f32 v86, v78, v82
    v_cvt_pk_bf16_f32 v87, v79, v83
    v_bitop3_b32 v84, v84, v7, v127 bitop3:0xb8
    v_bitop3_b32 v85, v85, v7, v127 bitop3:0xb8
    v_bitop3_b32 v86, v86, v7, v127 bitop3:0xb8
    v_bitop3_b32 v87, v87, v7, v127 bitop3:0xb8
    buffer_store_dwordx4 v[84:87], v99, s[8:11], s56 offen sc1
    s_setprio 0
L_final:
    s_mov_b64 s[12:13], s[48:49]
    s_mov_b32 s14, 0x280000
    s_mov_b32 s15, 0x00020000
    v_lshlrev_b32 v32, 16, v16
    v_and_b32 v33, 0xffff0000, v16
    v_lshlrev_b32 v34, 16, v17
    v_and_b32 v35, 0xffff0000, v17
    v_lshlrev_b32 v36, 16, v18
    v_and_b32 v37, 0xffff0000, v18
    v_lshlrev_b32 v38, 16, v19
    v_and_b32 v39, 0xffff0000, v19
    v_mov_b32 v24, 0x3b4d6042
    s_cmp_lt_u32 s24, 12
    s_cbranch_scc1 L_fgo
    s_waitcnt vmcnt(0)
L_fgo:
    s_cmp_ge_u32 s24, 10
    s_barrier
    s_cbranch_scc1 L_f2done
L_dpoll:
    buffer_load_dword v84, v92, s[8:11], s33 offen sc1
    buffer_load_dword v85, v92, s[8:11], s33 offen offset:256 sc1
    buffer_load_dword v86, v92, s[8:11], s33 offen offset:512 sc1
    buffer_load_dword v87, v92, s[8:11], s33 offen offset:768 sc1
    s_waitcnt vmcnt(0)
    v_bitop3_b32 v76, v84, v124, v126 bitop3:0x6a
    v_bitop3_b32 v77, v85, v124, v126 bitop3:0x6a
    v_bitop3_b32 v78, v86, v124, v126 bitop3:0x6a
    v_bitop3_b32 v79, v87, v124, v126 bitop3:0x6a
    v_bitop3_b32 v80, v84, v125, v126 bitop3:0x6a
    v_bitop3_b32 v81, v85, v125, v126 bitop3:0x6a
    v_bitop3_b32 v82, v86, v125, v126 bitop3:0x6a
    v_bitop3_b32 v83, v87, v125, v126 bitop3:0x6a
    v_mfma_f32_16x16x32_bf16 v[8:11], v[76:79], v[100:103], 0
    v_bitop3_b32 v84, v84, v85, v127 bitop3:0x7e
    v_mfma_f32_16x16x32_bf16 v[12:15], v[80:83], v[104:107], 0
    v_bitop3_b32 v86, v86, v87, v127 bitop3:0x7e
    v_mfma_f32_16x16x32_bf16 v[40:43], v[76:79], v[108:111], 0
    v_bitop3_b32 v84, v84, v86, v7 bitop3:0xa8
    v_mfma_f32_16x16x32_bf16 v[44:47], v[80:83], v[112:115], 0
    v_cmp_ne_u32 vcc, 0, v84
    s_cbranch_vccz L_dok
    s_add_u32 s29, s29, 1
    s_cmp_lt_u32 s29, 0x20000
    s_cbranch_scc1 L_dpoll
L_dok:
    s_nop 1
    v_sub_f32 v8, v8, v13
    v_add_f32 v9, v9, v12
    v_sub_f32 v10, v10, v15
    v_add_f32 v11, v11, v14
    v_cvt_pk_bf16_f32 v84, v8, v9
    v_cvt_pk_bf16_f32 v86, v10, v11
    v_sub_f32 v40, v40, v45
    v_add_f32 v41, v41, v44
    v_sub_f32 v42, v42, v47
    v_add_f32 v43, v43, v46
    v_cvt_pk_bf16_f32 v85, v40, v41
    v_cvt_pk_bf16_f32 v87, v42, v43
    ds_write_b64 v20, v[84:85] offset:10240
    ds_write_b64 v20, v[86:87] offset:11520
L_f2done:
    s_cmp_ge_u32 s24, 12
    s_waitcnt lgkmcnt(0)
    s_barrier
    s_cbranch_scc1 L_fin
    ds_read_b128 v[8:11], v21 offset:10240
    ds_read_b64 v[12:13], v22 offset:10304
    ds_read_b128 v[40:43], v21 offset:11520
    ds_read_b64 v[44:45], v22 offset:11584
    s_waitcnt lgkmcnt(2)
    v_mfma_f32_16x16x32_bf16 v[68:71], v[8:11], v[116:119], 0
    v_mfma_f32_16x16x32_bf16 v[68:71], v[10:13], v[120:123], v[68:71]
    s_waitcnt lgkmcnt(0)
    v_mfma_f32_16x16x32_bf16 v[72:75], v[40:43], v[116:119], 0
    v_mfma_f32_16x16x32_bf16 v[72:75], v[42:45], v[120:123], v[72:75]
    s_nop 4
    v_fmac_f32 v32, v24, v68
    v_fmac_f32 v33, v24, v69
    v_fmac_f32 v34, v24, v70
    v_fmac_f32 v35, v24, v71
    v_fmac_f32 v36, v24, v72
    v_fmac_f32 v37, v24, v73
    v_fmac_f32 v38, v24, v74
    v_fmac_f32 v39, v24, v75
    v_cvt_pk_bf16_f32 v84, v32, v33
    v_cvt_pk_bf16_f32 v85, v34, v35
    v_cvt_pk_bf16_f32 v86, v36, v37
    v_cvt_pk_bf16_f32 v87, v38, v39
    s_nop 0
    v_permlane16_swap_b32 v84, v86
    v_permlane16_swap_b32 v85, v87
    s_mov_b64 exec, s[60:61]
    buffer_store_dwordx4 v[84:87], v23, s[12:15], s35 offen sc1
    s_endpgm
    s_mov_b64 exec, -1
L_fin:
    s_lshl4_add_u32 s30, s2, s24
    s_cmp_lg_u32 s30, 15
    s_cbranch_scc1 L_noe
    s_mov_b64 exec, 1
    buffer_store_dword v6, v1, s[8:11], 0 offen sc1
L_noe:
L_end:
    s_endpgm
.p2align 8
.fill 640, 4, 0xbf810000
.section .rodata,"a"
.p2align 6
.amdhsa_kernel interleave_layers__spectral_gfnet__spectral_gfnet__prompt_kernel
  .amdhsa_next_free_vgpr 128
  .amdhsa_next_free_sgpr 102
  .amdhsa_accum_offset 128
  .amdhsa_group_segment_fixed_size 0
  .amdhsa_kernarg_size 72
  .amdhsa_user_sgpr_count 2
  .amdhsa_user_sgpr_kernarg_segment_ptr 1
  .amdhsa_system_sgpr_workgroup_id_x 1
.end_amdhsa_kernel
```
